```python
import torch

def _softmax(x, axis=-1):
    return torch.softmax(x, dim=axis)
def _gelu(x):
    return torch.nn.functional.gelu(x, approximate="tanh")
def _silu(x):
    return torch.nn.functional.silu(x)
def _sigmoid(x):
    return torch.sigmoid(x)
def _layernorm(x, axis=-1, eps=1e-5):
    m = x.mean(dim=axis, keepdim=True)
    v = x.var(dim=axis, keepdim=True, unbiased=False)
    return (x - m) / torch.sqrt(v + eps)
def _scatter_add(tgt, idx, src, axis=0):
    return tgt.clone().index_add_(axis, idx, src)
def _segment_sum(src, seg, n):
    out = torch.zeros((n,) + src.shape[1:], dtype=src.dtype)
    return out.index_add_(0, seg, src)
def _pad(x, pw):
    flat = tuple(v for pair in reversed(pw) for v in pair)
    return torch.nn.functional.pad(x, flat)

kernel_name = 'standalone__glu_gated_swiglu__decode'

def setup_inputs():

    _w = (lambda a: (lambda t: t.to(torch.bfloat16) if t.is_floating_point() else t)(torch.as_tensor(a)))
    B, S, D, F = 8, 1, 1024, 3584
    return {
        "x": _w((lambda *s: torch.randn(*s, dtype=torch.bfloat16) * 0.05)(B, S, D)),
        "w1": _w((lambda *s: torch.randn(*s, dtype=torch.bfloat16) * 0.05)(D, F) * (2.0 / D) ** 0.5),
        "w3": _w((lambda *s: torch.randn(*s, dtype=torch.bfloat16) * 0.05)(D, F) * (2.0 / D) ** 0.5),
        "w2": _w((lambda *s: torch.randn(*s, dtype=torch.bfloat16) * 0.05)(F, D) * (2.0 / F) ** 0.5),
    }

def reference(x, w1, w3, w2):
    gate = torch.einsum("bsd,df->bsf", x, w1)
    up = torch.einsum("bsd,df->bsf", x, w3)
    h = _silu(gate) * up
    out = torch.einsum("bsf,fd->bsd", h, w2)
    return out
```

```asm
; @launch grid=(256,1,1) block=(256,1,1) lds=81920
.amdgcn_target "amdgcn-amd-amdhsa--gfx950"
.text
.globl standalone__glu_gated_swiglu__decode_kernel
.p2align 8
.type standalone__glu_gated_swiglu__decode_kernel,@function
standalone__glu_gated_swiglu__decode_kernel:
    s_cmp_ge_u32 s2, 256
    s_cbranch_scc1 L_exit
    s_load_dwordx8 s[8:15], s[0:1], 0
    s_load_dwordx4 s[16:19], s[0:1], 32
    s_load_dwordx2 s[20:21], s[0:1], 48
    v_lshrrev_b32 v6, 6, v0
    v_and_b32 v7, 63, v0
    s_and_b32 s44, s2, 7
    v_readfirstlane_b32 s47, v6
    s_lshr_b32 s45, s2, 3
    s_mul_i32 s34, s44, 896
    s_mov_b32 s26, 7340032
    s_mov_b32 s27, 0x20000
    s_cmp_ge_u32 s45, 18
    s_cbranch_scc1 L_P0
    v_mul_u32_u24 v2, 9363, v7
    v_lshrrev_b32 v2, 16, v2
    v_mul_u32_u24 v2, 6272, v2
    v_lshl_add_u32 v4, v7, 7, v2
    v_mov_b32 v5, 2147483392
    v_cmp_gt_u32 vcc, 56, v7
    s_mul_i32 s54, s47, 9
    s_lshr_b32 s35, s45, 1
    v_cndmask_b32 v4, v5, v4, vcc
    s_add_u32 s54, s54, s35
    s_mul_i32 s54, s54, 57344
    s_add_u32 s48, s34, s54
    s_bitcmp1_b32 s45, 0
    s_waitcnt lgkmcnt(0)
    s_cselect_b32 s24, s12, s10
    s_cselect_b32 s25, s13, s11
    buffer_load_dword v8, v4, s[24:27], s48 offen sc1
    s_add_u32 s48, s48, 2064384
    buffer_load_dword v9, v4, s[24:27], s48 offen sc1
    s_add_u32 s48, s48, 2064384
    buffer_load_dword v10, v4, s[24:27], s48 offen sc1
    s_add_u32 s54, s45, 2
    s_lshr_b32 s54, s54, 2
    s_sub_u32 s54, s45, s54
    s_mul_i32 s35, s47, 14
    s_add_u32 s54, s54, s35
    s_and_b32 s35, s45, 19
    s_cmp_eq_u32 s35, 1
    s_cselect_b32 s49, 64, s54
    s_lshr_b32 s54, s49, 1
    s_mul_i32 s54, s54, 57344
    s_add_u32 s55, s34, s54
    s_add_u32 s55, s55, 6193152
    s_mov_b32 s30, 7340032
    s_mov_b32 s31, 0x20000
    s_bitcmp1_b32 s49, 0
    s_cselect_b32 s28, s12, s10
    s_cselect_b32 s29, s13, s11
    s_cmp_ge_u32 s49, 40
    s_cbranch_scc1 L_q_not3
    buffer_load_dword v11, v4, s[28:31], s55 offen sc1
    s_branch L_q_not3
L_P0:
    s_getpc_b64 s[4:5]
L_pc:
    v_lshlrev_b32 v1, 5, v0
    v_min_u32 v1, L_exit-L_pc, v1
    s_mov_b32 s31, 0x20000
    global_load_dword v12, v1, s[4:5]
    s_branch L_P
L_q_not3:
    s_cmp_ge_u32 s45, 16
    s_cbranch_scc1 L_R
L_q_notouch:
    s_mov_b32 s28, s14
    s_mov_b32 s29, s15
    s_mov_b32 s30, 7340032
    v_lshrrev_b32 v1, 4, v7
    v_mul_u32_u24 v2, 14, v6
    v_add_u32 v1, v1, v2
    v_and_b32 v3, 15, v7
    v_lshlrev_b32 v3, 4, v3
    v_lshrrev_b32 v16, 3, v1
    v_and_b32 v17, 7, v1
    v_lshl_add_u32 v16, v16, 5, v17
    v_lshl_add_u32 v224, v16, 11, v3
    v_add_u32 v1, 4, v1
    v_lshrrev_b32 v16, 3, v1
    v_and_b32 v17, 7, v1
    v_lshl_add_u32 v16, v16, 5, v17
    v_lshl_add_u32 v225, v16, 11, v3
    v_cmp_gt_u32 vcc, 32, v7
    s_lshr_b32 s54, s45, 3
    s_lshl_b32 s35, s44, 1
    v_cndmask_b32 v235, v5, v225, vcc
    s_add_u32 s54, s54, s35
    s_mul_i32 s49, s54, 458752
    s_and_b32 s35, s45, 7
    s_lshl_b32 s55, s35, 8
    s_add_u32 s49, s49, s55
    s_mov_b32 s56, s18
    s_mov_b32 s57, s19
    s_mov_b32 s58, 256
    s_mov_b32 s59, 0x20000
    v_mov_b32 v239, 0
    s_mov_b32 s36, s20
    s_mov_b32 s37, s21
    s_mov_b32 s38, 1507328
    s_mov_b32 s39, 0x20000
    s_mul_i32 s32, s54, 14336
    s_lshl_b32 s33, s35, 17
    s_lshl_b32 s54, s54, 9
    s_add_u32 s33, s33, s54
    s_add_u32 s33, s33, 458752
    s_mov_b32 s51, 0x05040100
    s_mov_b32 s52, 0x07060302
    v_lshrrev_b32 v1, 4, v7
    v_add_u32 v1, v1, v2
    v_bfe_u32 v3, v7, 3, 1
    v_lshl_add_u32 v1, v3, 2, v1
    v_lshrrev_b32 v3, 3, v1
    v_and_b32 v1, 7, v1
    v_lshlrev_b32 v1, 7, v1
    v_lshl_add_u32 v1, v3, 11, v1
    v_and_b32 v3, 40, v7
    v_cmp_ne_u32 vcc, 40, v3
    v_and_b32 v3, 7, v7
    v_lshl_add_u32 v226, v3, 4, v1
    v_cndmask_b32 v227, v5, v226, vcc
    v_cndmask_b32 v228, 0, -1, vcc
    v_lshrrev_b32 v2, 3, v7
    v_lshlrev_b32 v2, 7, v2
    v_lshl_add_u32 v2, v6, 12, v2
    v_lshrrev_b32 v1, 2, v7
    v_and_b32 v1, 4, v1
    v_xor_b32 v1, v1, v3
    v_xor_b32 v4, 0, v1
    v_lshl_add_u32 v229, v4, 4, v2
    v_xor_b32 v4, 1, v1
    v_lshl_add_u32 v230, v4, 4, v2
    v_xor_b32 v4, 2, v1
    v_lshl_add_u32 v231, v4, 4, v2
    v_xor_b32 v4, 3, v1
    v_lshl_add_u32 v232, v4, 4, v2
    v_lshrrev_b32 v1, 5, v0
    v_bfe_u32 v2, v7, 4, 1
    v_and_b32 v4, 7, v7
    v_xor_b32 v4, v4, v1
    v_and_b32 v16, 8, v7
    v_or_b32 v4, v4, v16
    v_lshlrev_b32 v4, 4, v4
    v_and_b32 v16, 3, v7
    v_lshl_add_u32 v4, v16, 10, v4
    v_lshl_add_u32 v4, v2, 9, v4
    v_bfe_u32 v16, v7, 2, 1
    v_lshl_add_u32 v233, v16, 8, v4
    v_lshrrev_b32 v1, 4, v0
    v_and_b32 v4, 15, v7
    v_lshlrev_b32 v4, 4, v4
    v_lshl_add_u32 v234, v1, 13, v4
    s_barrier
    buffer_load_dwordx4 v[32:35], v224, s[28:31], s49 offen nt
    buffer_load_dwordx4 v[48:51], v225, s[28:31], s49 offen nt
    s_addk_i32 s49, 16384
    buffer_load_dwordx4 v[36:39], v224, s[28:31], s49 offen nt
    buffer_load_dwordx4 v[52:55], v225, s[28:31], s49 offen nt
    s_addk_i32 s49, 16384
    buffer_load_dwordx4 v[40:43], v224, s[28:31], s49 offen nt
    buffer_load_dwordx4 v[56:59], v225, s[28:31], s49 offen nt
    s_addk_i32 s49, 16384
    buffer_load_dwordx4 v[44:47], v224, s[28:31], s49 offen nt
    buffer_load_dwordx4 v[60:63], v225, s[28:31], s49 offen nt
    s_addk_i32 s49, 16384
    buffer_load_dwordx4 v[64:67], v224, s[28:31], s49 offen nt
    buffer_load_dwordx4 v[80:83], v235, s[28:31], s49 offen nt
    s_addk_i32 s49, 16384
    buffer_load_dwordx4 v[68:71], v224, s[28:31], s49 offen nt
    buffer_load_dwordx4 v[84:87], v235, s[28:31], s49 offen nt
    s_addk_i32 s49, 16384
    buffer_load_dwordx4 v[72:75], v224, s[28:31], s49 offen nt
    buffer_load_dwordx4 v[88:91], v235, s[28:31], s49 offen nt
    s_addk_i32 s49, 16384
    buffer_load_dwordx4 v[76:79], v224, s[28:31], s49 offen nt
    buffer_load_dwordx4 v[92:95], v235, s[28:31], s49 offen nt
    s_waitcnt vmcnt(12)
    v_perm_b32 v96, v36, v32, s51
    v_perm_b32 v100, v36, v32, s52
    v_perm_b32 v104, v37, v33, s51
    v_perm_b32 v108, v37, v33, s52
    v_perm_b32 v112, v38, v34, s51
    v_perm_b32 v116, v38, v34, s52
    v_perm_b32 v120, v39, v35, s51
    v_perm_b32 v124, v39, v35, s52
    v_perm_b32 v98, v52, v48, s51
    v_perm_b32 v102, v52, v48, s52
    v_perm_b32 v106, v53, v49, s51
    v_perm_b32 v110, v53, v49, s52
    v_perm_b32 v114, v54, v50, s51
    v_perm_b32 v118, v54, v50, s52
    v_perm_b32 v122, v55, v51, s51
    v_perm_b32 v126, v55, v51, s52
    s_waitcnt vmcnt(8)
    v_perm_b32 v97, v44, v40, s51
    v_perm_b32 v101, v44, v40, s52
    v_perm_b32 v105, v45, v41, s51
    v_perm_b32 v109, v45, v41, s52
    v_perm_b32 v113, v46, v42, s51
    v_perm_b32 v117, v46, v42, s52
    v_perm_b32 v121, v47, v43, s51
    v_perm_b32 v125, v47, v43, s52
    v_perm_b32 v99, v60, v56, s51
    v_perm_b32 v103, v60, v56, s52
    v_perm_b32 v107, v61, v57, s51
    v_perm_b32 v111, v61, v57, s52
    v_perm_b32 v115, v62, v58, s51
    v_perm_b32 v119, v62, v58, s52
    v_perm_b32 v123, v63, v59, s51
    v_perm_b32 v127, v63, v59, s52
    s_waitcnt vmcnt(4)
    buffer_load_dwordx2 v[236:237], v239, s[56:59], 0 offen offset:192 sc0 sc1
    buffer_load_dwordx4 v[160:163], v226, s[36:39], s32 offen offset:0 sc0 sc1
    buffer_load_dwordx4 v[164:167], v226, s[36:39], s32 offen offset:1024 sc0 sc1
    buffer_load_dwordx4 v[168:171], v227, s[36:39], s32 offen offset:2048 sc0 sc1
    buffer_load_dwordx4 v[172:175], v227, s[36:39], s32 offen offset:3072 sc0 sc1
    v_perm_b32 v128, v68, v64, s51
    v_perm_b32 v132, v68, v64, s52
    v_perm_b32 v136, v69, v65, s51
    v_perm_b32 v140, v69, v65, s52
    v_perm_b32 v144, v70, v66, s51
    v_perm_b32 v148, v70, v66, s52
    v_perm_b32 v152, v71, v67, s51
    v_perm_b32 v156, v71, v67, s52
    v_perm_b32 v130, v84, v80, s51
    v_perm_b32 v134, v84, v80, s52
    v_perm_b32 v138, v85, v81, s51
    v_perm_b32 v142, v85, v81, s52
    v_perm_b32 v146, v86, v82, s51
    v_perm_b32 v150, v86, v82, s52
    v_perm_b32 v154, v87, v83, s51
    v_perm_b32 v158, v87, v83, s52
    s_waitcnt vmcnt(5)
    buffer_load_dwordx4 v[176:179], v226, s[36:39], s32 offen offset:0 sc0 sc1
    buffer_load_dwordx4 v[180:183], v226, s[36:39], s32 offen offset:1024 sc0 sc1
    buffer_load_dwordx4 v[184:187], v227, s[36:39], s32 offen offset:2048 sc0 sc1
    buffer_load_dwordx4 v[188:191], v227, s[36:39], s32 offen offset:3072 sc0 sc1
    v_perm_b32 v129, v76, v72, s51
    v_perm_b32 v133, v76, v72, s52
    v_perm_b32 v137, v77, v73, s51
    v_perm_b32 v141, v77, v73, s52
    v_perm_b32 v145, v78, v74, s51
    v_perm_b32 v149, v78, v74, s52
    v_perm_b32 v153, v79, v75, s51
    v_perm_b32 v157, v79, v75, s52
    v_perm_b32 v131, v92, v88, s51
    v_perm_b32 v135, v92, v88, s52
    v_perm_b32 v139, v93, v89, s51
    v_perm_b32 v143, v93, v89, s52
    v_perm_b32 v147, v94, v90, s51
    v_perm_b32 v151, v94, v90, s52
    v_perm_b32 v155, v95, v91, s51
    v_perm_b32 v159, v95, v91, s52
    s_mov_b32 s55, 0
    s_waitcnt vmcnt(4)
    v_bitop3_b32 v238, v236, 1, 1 bitop3:0x08
    v_bitop3_b32 v16, v161, v165, v236 bitop3:0x7e
    v_bitop3_b32 v17, v163, v167, v237 bitop3:0x7e
    v_bitop3_b32 v18, v169, v173, v236 bitop3:0x7e
    v_bitop3_b32 v19, v171, v175, v237 bitop3:0x7e
    v_or3_b32 v16, v16, v17, v238
    v_or_b32 v18, v18, v19
    v_and_or_b32 v16, v18, v228, v16
    v_cmp_ne_u32 vcc, 0, v16
    s_cbranch_vccz L_q_okA
    s_waitcnt vmcnt(0)
    v_bitop3_b32 v16, v177, v181, v236 bitop3:0x7e
    v_bitop3_b32 v17, v179, v183, v237 bitop3:0x7e
    v_bitop3_b32 v18, v185, v189, v236 bitop3:0x7e
    v_bitop3_b32 v19, v187, v191, v237 bitop3:0x7e
    v_or3_b32 v16, v16, v17, v238
    v_or_b32 v18, v18, v19
    v_and_or_b32 v16, v18, v228, v16
    v_cmp_ne_u32 vcc, 0, v16
    s_cbranch_vccnz L_q_poll
    v_mov_b32 v160, v176
    v_mov_b32 v162, v178
    v_mov_b32 v164, v180
    v_mov_b32 v166, v182
    v_mov_b32 v168, v184
    v_mov_b32 v170, v186
    v_mov_b32 v172, v188
    v_mov_b32 v174, v190
    s_branch L_q_okA
L_q_poll:
    s_and_b32 s54, s55, 7
    s_cmp_eq_u32 s54, 7
    s_cselect_b32 s54, 229376, 0
    s_add_u32 s54, s54, s32
    buffer_load_dwordx2 v[236:237], v239, s[56:59], 0 offen offset:192 sc0 sc1
    buffer_load_dwordx4 v[160:163], v226, s[36:39], s54 offen offset:0 sc0 sc1
    buffer_load_dwordx4 v[164:167], v226, s[36:39], s54 offen offset:1024 sc0 sc1
    buffer_load_dwordx4 v[168:171], v227, s[36:39], s54 offen offset:2048 sc0 sc1
    buffer_load_dwordx4 v[172:175], v227, s[36:39], s54 offen offset:3072 sc0 sc1
    s_add_u32 s55, s55, 1
    s_cmp_gt_u32 s55, 262144
    s_waitcnt vmcnt(0)
    s_cbranch_scc1 L_q_okA
    v_bitop3_b32 v238, v236, 1, 1 bitop3:0x08
    v_bitop3_b32 v16, v161, v165, v236 bitop3:0x7e
    v_bitop3_b32 v17, v163, v167, v237 bitop3:0x7e
    v_bitop3_b32 v18, v169, v173, v236 bitop3:0x7e
    v_bitop3_b32 v19, v171, v175, v237 bitop3:0x7e
    v_or3_b32 v16, v16, v17, v238
    v_or_b32 v18, v18, v19
    v_and_or_b32 v16, v18, v228, v16
    v_cmp_ne_u32 vcc, 0, v16
    s_cbranch_vccnz L_q_poll
L_q_okA:
    v_lshlrev_b32 v16, 16, v160
    v_and_b32 v17, 0xffff0000, v160
    v_lshlrev_b32 v20, 16, v164
    v_and_b32 v21, 0xffff0000, v164
    v_lshlrev_b32 v18, 16, v162
    v_and_b32 v19, 0xffff0000, v162
    v_lshlrev_b32 v22, 16, v166
    v_and_b32 v23, 0xffff0000, v166
    v_pk_mul_f32 v[16:17], v[16:17], v[20:21]
    v_pk_mul_f32 v[18:19], v[18:19], v[22:23]
    v_cvt_pk_bf16_f32 v8, v16, v17
    v_cvt_pk_bf16_f32 v9, v18, v19
    v_lshlrev_b32 v24, 16, v168
    v_mov_b32_dpp v10, v8 row_ror:8 row_mask:0xf bank_mask:0xf
    v_mov_b32_dpp v11, v9 row_ror:8 row_mask:0xf bank_mask:0xf
    v_and_b32 v25, 0xffff0000, v168
    v_lshlrev_b32 v28, 16, v172
    v_mfma_f32_16x16x32_bf16 v[192:195], v[96:99], v[8:11], 0
    v_and_b32 v29, 0xffff0000, v172
    v_lshlrev_b32 v26, 16, v170
    v_mfma_f32_16x16x32_bf16 v[196:199], v[100:103], v[8:11], 0
    v_and_b32 v27, 0xffff0000, v170
    v_lshlrev_b32 v30, 16, v174
    v_mfma_f32_16x16x32_bf16 v[200:203], v[104:107], v[8:11], 0
    v_and_b32 v31, 0xffff0000, v174
    v_pk_mul_f32 v[24:25], v[24:25], v[28:29]
    v_mfma_f32_16x16x32_bf16 v[204:207], v[108:111], v[8:11], 0
    v_pk_mul_f32 v[26:27], v[26:27], v[30:31]
    v_cvt_pk_bf16_f32 v12, v24, v25
    v_mfma_f32_16x16x32_bf16 v[208:211], v[112:115], v[8:11], 0
    v_cvt_pk_bf16_f32 v13, v26, v27
    s_nop 0
    v_mfma_f32_16x16x32_bf16 v[212:215], v[116:119], v[8:11], 0
    v_mov_b32_dpp v14, v12 row_ror:8 row_mask:0xf bank_mask:0xf
    v_mov_b32_dpp v15, v13 row_ror:8 row_mask:0xf bank_mask:0xf
    v_mfma_f32_16x16x32_bf16 v[216:219], v[120:123], v[8:11], 0
    v_mfma_f32_16x16x32_bf16 v[220:223], v[124:127], v[8:11], 0
L_q_s1:
    v_mfma_f32_16x16x32_bf16 v[192:195], v[128:131], v[12:15], v[192:195]
    v_mov_b32 v17, v236
    v_mfma_f32_16x16x32_bf16 v[196:199], v[132:135], v[12:15], v[196:199]
    v_mov_b32 v19, v237
    v_mfma_f32_16x16x32_bf16 v[200:203], v[136:139], v[12:15], v[200:203]
    v_mov_b32 v21, v236
    v_mfma_f32_16x16x32_bf16 v[204:207], v[140:143], v[12:15], v[204:207]
    v_mov_b32 v23, v237
    v_mfma_f32_16x16x32_bf16 v[208:211], v[144:147], v[12:15], v[208:211]
    v_mfma_f32_16x16x32_bf16 v[212:215], v[148:151], v[12:15], v[212:215]
    v_mfma_f32_16x16x32_bf16 v[216:219], v[152:155], v[12:15], v[216:219]
    v_mfma_f32_16x16x32_bf16 v[220:223], v[156:159], v[12:15], v[220:223]
    s_nop 1
    v_mov_b32_dpp v192, v196 row_ror:8 row_mask:0xf bank_mask:0xc
    v_mov_b32_dpp v193, v197 row_ror:8 row_mask:0xf bank_mask:0xc
    v_mov_b32_dpp v194, v198 row_ror:8 row_mask:0xf bank_mask:0xc
    v_mov_b32_dpp v195, v199 row_ror:8 row_mask:0xf bank_mask:0xc
    v_mov_b32_dpp v200, v204 row_ror:8 row_mask:0xf bank_mask:0xc
    v_mov_b32_dpp v201, v205 row_ror:8 row_mask:0xf bank_mask:0xc
    v_mov_b32_dpp v202, v206 row_ror:8 row_mask:0xf bank_mask:0xc
    v_mov_b32_dpp v203, v207 row_ror:8 row_mask:0xf bank_mask:0xc
    ds_write_b128 v229, v[192:195] offset:0
    v_mov_b32_dpp v208, v212 row_ror:8 row_mask:0xf bank_mask:0xc
    v_mov_b32_dpp v209, v213 row_ror:8 row_mask:0xf bank_mask:0xc
    v_mov_b32_dpp v210, v214 row_ror:8 row_mask:0xf bank_mask:0xc
    v_mov_b32_dpp v211, v215 row_ror:8 row_mask:0xf bank_mask:0xc
    ds_write_b128 v230, v[200:203] offset:1024
    v_mov_b32_dpp v216, v220 row_ror:8 row_mask:0xf bank_mask:0xc
    v_mov_b32_dpp v217, v221 row_ror:8 row_mask:0xf bank_mask:0xc
    v_mov_b32_dpp v218, v222 row_ror:8 row_mask:0xf bank_mask:0xc
    v_mov_b32_dpp v219, v223 row_ror:8 row_mask:0xf bank_mask:0xc
    ds_write_b128 v231, v[208:211] offset:2048
    ds_write_b128 v232, v[216:219] offset:3072
    s_waitcnt lgkmcnt(0)
    s_barrier
    ds_read_b128 v[32:35], v233 offset:0
    ds_read_b128 v[36:39], v233 offset:4096
    ds_read_b128 v[40:43], v233 offset:8192
    ds_read_b128 v[44:47], v233 offset:12288
    s_waitcnt lgkmcnt(2)
    v_pk_add_f32 v[32:33], v[32:33], v[36:37]
    v_pk_add_f32 v[34:35], v[34:35], v[38:39]
    s_waitcnt lgkmcnt(0)
    v_pk_add_f32 v[40:41], v[40:41], v[44:45]
    v_pk_add_f32 v[42:43], v[42:43], v[46:47]
    v_add_f32 v16, v32, v40
    v_add_f32 v18, v33, v41
    buffer_store_dwordx4 v[16:19], v234, s[36:39], s33 offen sc0 sc1
    v_add_f32 v20, v34, v42
    v_add_f32 v22, v35, v43
    buffer_store_dwordx4 v[20:23], v234, s[36:39], s33 offen offset:256 sc0 sc1
    s_endpgm
L_P:
    s_sub_u32 s45, s45, 18
    s_memrealtime s[60:61]
    s_lshr_b32 s54, s45, 1
    v_lshrrev_b32 v1, 3, v0
    v_and_b32 v2, 7, v0
    v_mul_u32_u24 v3, 28672, v1
    v_lshl_add_u32 v3, v2, 4, v3
    v_lshlrev_b32 v4, 3, v1
    v_lshl_add_u32 v4, v2, 11, v4
    s_lshl_b32 s35, s54, 7
    s_add_u32 s48, s34, s35
    s_mov_b32 s30, 16384
    s_bitcmp1_b32 s45, 0
    s_waitcnt lgkmcnt(0)
    s_cselect_b32 s24, s12, s10
    s_cselect_b32 s25, s13, s11
    s_mov_b32 s56, s18
    s_mov_b32 s57, s19
    s_mov_b32 s58, 256
    s_mov_b32 s59, 0x20000
    v_mov_b32 v239, 0
    s_lshl_b32 s35, s2, 2
    s_add_u32 s35, s35, s47
    s_cmp_lg_u32 s35, 578
    s_cbranch_scc1 L_nopub
    s_or_b32 s60, s60, 1
    s_mul_i32 s62, s60, 0x9e3779b1
    s_xor_b32 s61, s61, s62
    v_mov_b32 v26, s60
    v_mov_b32 v27, s61
    s_mov_b64 exec, 1
    buffer_store_dwordx2 v[26:27], v239, s[56:59], 0 offen offset:192 sc0 sc1
    s_mov_b64 exec, -1
L_nopub:
    s_mov_b32 s28, s8
    s_mov_b32 s29, s9
    buffer_load_dwordx2 v[8:9], v4, s[28:31], 0 offen offset:0
    buffer_load_dwordx2 v[10:11], v4, s[28:31], 0 offen offset:256
    buffer_load_dwordx2 v[12:13], v4, s[28:31], 0 offen offset:512
    buffer_load_dwordx2 v[14:15], v4, s[28:31], 0 offen offset:768
    buffer_load_dwordx2 v[16:17], v4, s[28:31], 0 offen offset:1024
    buffer_load_dwordx2 v[18:19], v4, s[28:31], 0 offen offset:1280
    buffer_load_dwordx2 v[20:21], v4, s[28:31], 0 offen offset:1536
    buffer_load_dwordx2 v[22:23], v4, s[28:31], 0 offen offset:1792
    s_mov_b32 s36, s20
    s_mov_b32 s37, s21
    s_mov_b32 s38, 1507328
    s_mov_b32 s39, 0x20000
    s_mov_b32 s51, 0x05040100
    s_mov_b32 s52, 0x07060302
    s_mul_i32 s32, s44, 14
    s_lshl_b32 s54, s54, 1
    s_add_u32 s32, s32, s54
    s_lshr_b32 s54, s47, 1
    s_add_u32 s32, s32, s54
    s_lshl_b32 s32, s32, 11
    s_and_b32 s54, s45, 1
    s_lshl_b32 s54, s54, 10
    s_add_u32 s32, s32, s54
    v_lshlrev_b32 v25, 4, v7
    buffer_load_dword v28, v25, s[36:39], s32 offen
    v_lshlrev_b32 v5, 4, v2
    v_lshl_add_u32 v5, v6, 11, v5
    v_bfe_u32 v1, v7, 4, 1
    v_lshl_add_u32 v5, v1, 10, v5
    v_bfe_u32 v1, v7, 3, 1
    v_lshl_add_u32 v5, v1, 8, v5
    v_lshrrev_b32 v1, 5, v7
    v_lshl_add_u32 v5, v1, 7, v5
    v_lshlrev_b32 v24, 3, v0
    v_and_b32 v29, 0x3ff, v24
    buffer_load_dwordx4 v[32:35], v3, s[24:27], s48 offen sc1
    s_addk_i32 s48, 7168
    buffer_load_dwordx4 v[36:39], v3, s[24:27], s48 offen sc1
    s_addk_i32 s48, 7168
    buffer_load_dwordx4 v[40:43], v3, s[24:27], s48 offen sc1
    s_addk_i32 s48, 7168
    buffer_load_dwordx4 v[44:47], v3, s[24:27], s48 offen sc1
    s_add_u32 s48, s48, 896000
    buffer_load_dwordx4 v[48:51], v3, s[24:27], s48 offen sc1
    s_addk_i32 s48, 7168
    buffer_load_dwordx4 v[52:55], v3, s[24:27], s48 offen sc1
    s_addk_i32 s48, 7168
    buffer_load_dwordx4 v[56:59], v3, s[24:27], s48 offen sc1
    s_addk_i32 s48, 7168
    buffer_load_dwordx4 v[60:63], v3, s[24:27], s48 offen sc1
    s_add_u32 s48, s48, 896000
    s_waitcnt vmcnt(4)
    buffer_load_dwordx4 v[64:67], v3, s[24:27], s48 offen sc1
    s_addk_i32 s48, 7168
    buffer_load_dwordx4 v[68:71], v3, s[24:27], s48 offen sc1
    s_addk_i32 s48, 7168
    buffer_load_dwordx4 v[72:75], v3, s[24:27], s48 offen sc1
    s_addk_i32 s48, 7168
    buffer_load_dwordx4 v[76:79], v3, s[24:27], s48 offen sc1
    s_add_u32 s48, s48, 896000
    v_perm_b32 v160, v36, v32, s51
    v_perm_b32 v164, v36, v32, s52
    v_perm_b32 v168, v37, v33, s51
    v_perm_b32 v172, v37, v33, s52
    v_perm_b32 v176, v38, v34, s51
    v_perm_b32 v180, v38, v34, s52
    v_perm_b32 v184, v39, v35, s51
    v_perm_b32 v188, v39, v35, s52
    v_perm_b32 v161, v44, v40, s51
    v_perm_b32 v165, v44, v40, s52
    v_perm_b32 v169, v45, v41, s51
    v_perm_b32 v173, v45, v41, s52
    v_perm_b32 v177, v46, v42, s51
    v_perm_b32 v181, v46, v42, s52
    v_perm_b32 v185, v47, v43, s51
    v_perm_b32 v189, v47, v43, s52
    s_waitcnt vmcnt(4)
    buffer_load_dwordx4 v[80:83], v3, s[24:27], s48 offen sc1
    s_addk_i32 s48, 7168
    buffer_load_dwordx4 v[84:87], v3, s[24:27], s48 offen sc1
    s_addk_i32 s48, 7168
    buffer_load_dwordx4 v[88:91], v3, s[24:27], s48 offen sc1
    s_addk_i32 s48, 7168
    buffer_load_dwordx4 v[92:95], v3, s[24:27], s48 offen sc1
    s_add_u32 s48, s48, 896000
    v_perm_b32 v162, v52, v48, s51
    v_perm_b32 v166, v52, v48, s52
    v_perm_b32 v170, v53, v49, s51
    v_perm_b32 v174, v53, v49, s52
    v_perm_b32 v178, v54, v50, s51
    v_perm_b32 v182, v54, v50, s52
    v_perm_b32 v186, v55, v51, s51
    v_perm_b32 v190, v55, v51, s52
    v_perm_b32 v163, v60, v56, s51
    v_perm_b32 v167, v60, v56, s52
    v_perm_b32 v171, v61, v57, s51
    v_perm_b32 v175, v61, v57, s52
    v_perm_b32 v179, v62, v58, s51
    v_perm_b32 v183, v62, v58, s52
    v_perm_b32 v187, v63, v59, s51
    v_perm_b32 v191, v63, v59, s52
    v_mfma_f32_16x16x32_bf16 v[192:195], v[160:163], v[8:11], 0
    v_mfma_f32_16x16x32_bf16 v[196:199], v[164:167], v[8:11], 0
    v_mfma_f32_16x16x32_bf16 v[200:203], v[168:171], v[8:11], 0
    v_mfma_f32_16x16x32_bf16 v[204:207], v[172:175], v[8:11], 0
    v_mfma_f32_16x16x32_bf16 v[208:211], v[176:179], v[8:11], 0
    v_mfma_f32_16x16x32_bf16 v[212:215], v[180:183], v[8:11], 0
    v_mfma_f32_16x16x32_bf16 v[216:219], v[184:187], v[8:11], 0
    v_mfma_f32_16x16x32_bf16 v[220:223], v[188:191], v[8:11], 0
    s_waitcnt vmcnt(4)
    buffer_load_dwordx4 v[96:99], v3, s[24:27], s48 offen sc1
    s_addk_i32 s48, 7168
    buffer_load_dwordx4 v[100:103], v3, s[24:27], s48 offen sc1
    s_addk_i32 s48, 7168
    buffer_load_dwordx4 v[104:107], v3, s[24:27], s48 offen sc1
    s_addk_i32 s48, 7168
    buffer_load_dwordx4 v[108:111], v3, s[24:27], s48 offen sc1
    s_add_u32 s48, s48, 896000
    v_perm_b32 v160, v68, v64, s51
    v_perm_b32 v164, v68, v64, s52
    v_perm_b32 v168, v69, v65, s51
    v_perm_b32 v172, v69, v65, s52
    v_perm_b32 v176, v70, v66, s51
    v_perm_b32 v180, v70, v66, s52
    v_perm_b32 v184, v71, v67, s51
    v_perm_b32 v188, v71, v67, s52
    v_perm_b32 v161, v76, v72, s51
    v_perm_b32 v165, v76, v72, s52
    v_perm_b32 v169, v77, v73, s51
    v_perm_b32 v173, v77, v73, s52
    v_perm_b32 v177, v78, v74, s51
    v_perm_b32 v181, v78, v74, s52
    v_perm_b32 v185, v79, v75, s51
    v_perm_b32 v189, v79, v75, s52
    s_waitcnt vmcnt(4)
    buffer_load_dwordx4 v[112:115], v3, s[24:27], s48 offen sc1
    s_addk_i32 s48, 7168
    buffer_load_dwordx4 v[116:119], v3, s[24:27], s48 offen sc1
    s_addk_i32 s48, 7168
    buffer_load_dwordx4 v[120:123], v3, s[24:27], s48 offen sc1
    s_addk_i32 s48, 7168
    buffer_load_dwordx4 v[124:127], v3, s[24:27], s48 offen sc1
    s_add_u32 s48, s48, 896000
    v_perm_b32 v162, v84, v80, s51
    v_perm_b32 v166, v84, v80, s52
    v_perm_b32 v170, v85, v81, s51
    v_perm_b32 v174, v85, v81, s52
    v_perm_b32 v178, v86, v82, s51
    v_perm_b32 v182, v86, v82, s52
    v_perm_b32 v186, v87, v83, s51
    v_perm_b32 v190, v87, v83, s52
    v_perm_b32 v163, v92, v88, s51
    v_perm_b32 v167, v92, v88, s52
    v_perm_b32 v171, v93, v89, s51
    v_perm_b32 v175, v93, v89, s52
    v_perm_b32 v179, v94, v90, s51
    v_perm_b32 v183, v94, v90, s52
    v_perm_b32 v187, v95, v91, s51
    v_perm_b32 v191, v95, v91, s52
    v_mfma_f32_16x16x32_bf16 v[192:195], v[160:163], v[12:15], v[192:195]
    v_mfma_f32_16x16x32_bf16 v[196:199], v[164:167], v[12:15], v[196:199]
    v_mfma_f32_16x16x32_bf16 v[200:203], v[168:171], v[12:15], v[200:203]
    v_mfma_f32_16x16x32_bf16 v[204:207], v[172:175], v[12:15], v[204:207]
    v_mfma_f32_16x16x32_bf16 v[208:211], v[176:179], v[12:15], v[208:211]
    v_mfma_f32_16x16x32_bf16 v[212:215], v[180:183], v[12:15], v[212:215]
    v_mfma_f32_16x16x32_bf16 v[216:219], v[184:187], v[12:15], v[216:219]
    v_mfma_f32_16x16x32_bf16 v[220:223], v[188:191], v[12:15], v[220:223]
    s_waitcnt vmcnt(4)
    buffer_load_dwordx4 v[128:131], v3, s[24:27], s48 offen sc1
    s_addk_i32 s48, 7168
    buffer_load_dwordx4 v[132:135], v3, s[24:27], s48 offen sc1
    s_addk_i32 s48, 7168
    buffer_load_dwordx4 v[136:139], v3, s[24:27], s48 offen sc1
    s_addk_i32 s48, 7168
    buffer_load_dwordx4 v[140:143], v3, s[24:27], s48 offen sc1
    s_add_u32 s48, s48, 896000
    v_perm_b32 v160, v100, v96, s51
    v_perm_b32 v164, v100, v96, s52
    v_perm_b32 v168, v101, v97, s51
    v_perm_b32 v172, v101, v97, s52
    v_perm_b32 v176, v102, v98, s51
    v_perm_b32 v180, v102, v98, s52
    v_perm_b32 v184, v103, v99, s51
    v_perm_b32 v188, v103, v99, s52
    v_perm_b32 v161, v108, v104, s51
    v_perm_b32 v165, v108, v104, s52
    v_perm_b32 v169, v109, v105, s51
    v_perm_b32 v173, v109, v105, s52
    v_perm_b32 v177, v110, v106, s51
    v_perm_b32 v181, v110, v106, s52
    v_perm_b32 v185, v111, v107, s51
    v_perm_b32 v189, v111, v107, s52
    s_waitcnt vmcnt(4)
    buffer_load_dwordx4 v[144:147], v3, s[24:27], s48 offen sc1
    s_addk_i32 s48, 7168
    buffer_load_dwordx4 v[148:151], v3, s[24:27], s48 offen sc1
    s_addk_i32 s48, 7168
    buffer_load_dwordx4 v[152:155], v3, s[24:27], s48 offen sc1
    s_addk_i32 s48, 7168
    buffer_load_dwordx4 v[156:159], v3, s[24:27], s48 offen sc1
    buffer_load_dwordx2 v[236:237], v239, s[56:59], 0 offen offset:192 sc0 sc1
    v_perm_b32 v162, v116, v112, s51
    v_perm_b32 v166, v116, v112, s52
    v_perm_b32 v170, v117, v113, s51
    v_perm_b32 v174, v117, v113, s52
    v_perm_b32 v178, v118, v114, s51
    v_perm_b32 v182, v118, v114, s52
    v_perm_b32 v186, v119, v115, s51
    v_perm_b32 v190, v119, v115, s52
    v_perm_b32 v163, v124, v120, s51
    v_perm_b32 v167, v124, v120, s52
    v_perm_b32 v171, v125, v121, s51
    v_perm_b32 v175, v125, v121, s52
    v_perm_b32 v179, v126, v122, s51
    v_perm_b32 v183, v126, v122, s52
    v_perm_b32 v187, v127, v123, s51
    v_perm_b32 v191, v127, v123, s52
    v_mfma_f32_16x16x32_bf16 v[192:195], v[160:163], v[16:19], v[192:195]
    v_mfma_f32_16x16x32_bf16 v[196:199], v[164:167], v[16:19], v[196:199]
    v_mfma_f32_16x16x32_bf16 v[200:203], v[168:171], v[16:19], v[200:203]
    v_mfma_f32_16x16x32_bf16 v[204:207], v[172:175], v[16:19], v[204:207]
    v_mfma_f32_16x16x32_bf16 v[208:211], v[176:179], v[16:19], v[208:211]
    v_mfma_f32_16x16x32_bf16 v[212:215], v[180:183], v[16:19], v[212:215]
    v_mfma_f32_16x16x32_bf16 v[216:219], v[184:187], v[16:19], v[216:219]
    v_mfma_f32_16x16x32_bf16 v[220:223], v[188:191], v[16:19], v[220:223]
    s_waitcnt vmcnt(5)
    v_perm_b32 v160, v132, v128, s51
    v_perm_b32 v164, v132, v128, s52
    v_perm_b32 v168, v133, v129, s51
    v_perm_b32 v172, v133, v129, s52
    v_perm_b32 v176, v134, v130, s51
    v_perm_b32 v180, v134, v130, s52
    v_perm_b32 v184, v135, v131, s51
    v_perm_b32 v188, v135, v131, s52
    v_perm_b32 v161, v140, v136, s51
    v_perm_b32 v165, v140, v136, s52
    v_perm_b32 v169, v141, v137, s51
    v_perm_b32 v173, v141, v137, s52
    v_perm_b32 v177, v142, v138, s51
    v_perm_b32 v181, v142, v138, s52
    v_perm_b32 v185, v143, v139, s51
    v_perm_b32 v189, v143, v139, s52
    s_waitcnt vmcnt(3)
    v_perm_b32 v162, v148, v144, s51
    v_perm_b32 v166, v148, v144, s52
    v_perm_b32 v170, v149, v145, s51
    v_perm_b32 v174, v149, v145, s52
    v_perm_b32 v178, v150, v146, s51
    v_perm_b32 v182, v150, v146, s52
    v_perm_b32 v186, v151, v147, s51
    v_perm_b32 v190, v151, v147, s52
    s_waitcnt vmcnt(1)
    v_perm_b32 v163, v156, v152, s51
    v_perm_b32 v167, v156, v152, s52
    v_perm_b32 v171, v157, v153, s51
    v_perm_b32 v175, v157, v153, s52
    v_perm_b32 v179, v158, v154, s51
    v_perm_b32 v183, v158, v154, s52
    v_perm_b32 v187, v159, v155, s51
    v_perm_b32 v191, v159, v155, s52
    v_mfma_f32_16x16x32_bf16 v[192:195], v[160:163], v[20:23], v[192:195]
    v_mfma_f32_16x16x32_bf16 v[196:199], v[164:167], v[20:23], v[196:199]
    v_mfma_f32_16x16x32_bf16 v[200:203], v[168:171], v[20:23], v[200:203]
    v_mfma_f32_16x16x32_bf16 v[204:207], v[172:175], v[20:23], v[204:207]
    v_mfma_f32_16x16x32_bf16 v[208:211], v[176:179], v[20:23], v[208:211]
    v_mfma_f32_16x16x32_bf16 v[212:215], v[180:183], v[20:23], v[212:215]
    v_mfma_f32_16x16x32_bf16 v[216:219], v[184:187], v[20:23], v[216:219]
    v_mfma_f32_16x16x32_bf16 v[220:223], v[188:191], v[20:23], v[220:223]
    s_nop 1
    v_permlane32_swap_b32 v192, v196
    v_permlane32_swap_b32 v193, v197
    v_permlane32_swap_b32 v194, v198
    v_permlane32_swap_b32 v195, v199
    v_permlane32_swap_b32 v200, v204
    v_permlane32_swap_b32 v201, v205
    v_permlane32_swap_b32 v202, v206
    v_permlane32_swap_b32 v203, v207
    v_add_f32_dpp v192, v196, v192 row_ror:8 row_mask:0xf bank_mask:0x3
    v_add_f32_dpp v193, v197, v193 row_ror:8 row_mask:0xf bank_mask:0x3
    v_add_f32_dpp v194, v198, v194 row_ror:8 row_mask:0xf bank_mask:0x3
    v_add_f32_dpp v195, v199, v195 row_ror:8 row_mask:0xf bank_mask:0x3
    v_add_f32_dpp v192, v200, v204 row_ror:8 row_mask:0xf bank_mask:0xc
    v_add_f32_dpp v193, v201, v205 row_ror:8 row_mask:0xf bank_mask:0xc
    v_add_f32_dpp v194, v202, v206 row_ror:8 row_mask:0xf bank_mask:0xc
    v_add_f32_dpp v195, v203, v207 row_ror:8 row_mask:0xf bank_mask:0xc
    ds_write_b128 v5, v[192:195] offset:0
    v_permlane32_swap_b32 v208, v212
    v_permlane32_swap_b32 v209, v213
    v_permlane32_swap_b32 v210, v214
    v_permlane32_swap_b32 v211, v215
    v_permlane32_swap_b32 v216, v220
    v_permlane32_swap_b32 v217, v221
    v_permlane32_swap_b32 v218, v222
    v_permlane32_swap_b32 v219, v223
    v_add_f32_dpp v208, v212, v208 row_ror:8 row_mask:0xf bank_mask:0x3
    v_add_f32_dpp v209, v213, v209 row_ror:8 row_mask:0xf bank_mask:0x3
    v_add_f32_dpp v210, v214, v210 row_ror:8 row_mask:0xf bank_mask:0x3
    v_add_f32_dpp v211, v215, v211 row_ror:8 row_mask:0xf bank_mask:0x3
    v_add_f32_dpp v208, v216, v220 row_ror:8 row_mask:0xf bank_mask:0xc
    v_add_f32_dpp v209, v217, v221 row_ror:8 row_mask:0xf bank_mask:0xc
    v_add_f32_dpp v210, v218, v222 row_ror:8 row_mask:0xf bank_mask:0xc
    v_add_f32_dpp v211, v219, v223 row_ror:8 row_mask:0xf bank_mask:0xc
    ds_write_b128 v5, v[208:211] offset:512
    s_waitcnt vmcnt(0)
    v_cmp_eq_u32 vcc, 0, v236
    s_cbranch_vccz L_pn_ok
    s_mov_b32 s55, 0
L_pn_re:
    buffer_load_dwordx2 v[236:237], v239, s[56:59], 0 offen offset:192 sc0 sc1
    s_add_u32 s55, s55, 1
    s_cmp_gt_u32 s55, 262144
    s_waitcnt vmcnt(0)
    s_cbranch_scc1 L_pn_ok
    v_cmp_eq_u32 vcc, 0, v236
    s_cbranch_vccnz L_pn_re
L_pn_ok:
    v_and_b32 v1, 1, v0
    v_cmp_eq_u32 vcc, 0, v1
    s_nop 1
    v_cndmask_b32 v17, v237, v236, vcc
    s_waitcnt lgkmcnt(0)
    s_barrier
    ds_read_b64 v[32:33], v24 offset:0
    ds_read_b64 v[34:35], v24 offset:2048
    ds_read_b64 v[36:37], v24 offset:4096
    ds_read_b64 v[38:39], v24 offset:6144
    s_bitcmp1_b32 s45, 0
    s_waitcnt lgkmcnt(2)
    v_pk_add_f32 v[32:33], v[32:33], v[34:35]
    s_waitcnt lgkmcnt(0)
    v_pk_add_f32 v[36:37], v[36:37], v[38:39]
    v_pk_add_f32 v[32:33], v[32:33], v[36:37]
    v_cvt_pk_bf16_f32 v16, v32, v33
    s_cbranch_scc1 L_pub1
    v_lshlrev_b32 v32, 16, v16
    v_and_b32 v33, 0xffff0000, v16
    v_mul_f32 v36, 0xbfb8aa3b, v32
    v_mul_f32 v37, 0xbfb8aa3b, v33
    v_exp_f32 v36, v36
    v_exp_f32 v37, v37
    v_add_f32 v36, 1.0, v36
    v_add_f32 v37, 1.0, v37
    v_rcp_f32 v36, v36
    v_rcp_f32 v37, v37
    v_mul_f32 v32, v32, v36
    v_mul_f32 v33, v33, v37
    v_cvt_pk_bf16_f32 v16, v32, v33
L_pub1:
    buffer_store_dwordx2 v[16:17], v29, s[36:39], s32 offen
    s_add_u32 s32, s32, 229376
    s_barrier
    buffer_store_dwordx2 v[16:17], v29, s[36:39], s32 offen sc0 sc1
L_P_other:
    s_cmp_lg_u32 s47, 3
    s_cbranch_scc1 L_end
    s_branch L_red
L_R:
    s_sub_u32 s45, s45, 2
    s_cmp_lg_u32 s47, 3
    s_cbranch_scc1 L_end
    s_mov_b32 s36, s20
    s_mov_b32 s37, s21
    s_mov_b32 s38, 1507328
    s_mov_b32 s39, 0x20000
    s_mov_b32 s56, s18
    s_mov_b32 s57, s19
    s_mov_b32 s58, 256
    s_mov_b32 s59, 0x20000
    v_mov_b32 v239, 0
    v_lshlrev_b32 v25, 4, v7
    s_waitcnt vmcnt(0)
    buffer_load_dwordx2 v[236:237], v239, s[56:59], 0 offen offset:192 sc0 sc1
    s_waitcnt vmcnt(0)
    v_cmp_eq_u32 vcc, 0, v236
    s_cbranch_vccz L_rn_ok
    s_mov_b32 s55, 0
L_rn_re:
    buffer_load_dwordx2 v[236:237], v239, s[56:59], 0 offen offset:192 sc0 sc1
    s_add_u32 s55, s55, 1
    s_cmp_gt_u32 s55, 262144
    s_waitcnt vmcnt(0)
    s_cbranch_scc1 L_rn_ok
    v_cmp_eq_u32 vcc, 0, v236
    s_cbranch_vccnz L_rn_re
L_rn_ok:
L_red:
    s_lshl_b32 s46, s44, 4
    s_add_u32 s46, s46, s45
    s_mov_b32 s40, s16
    s_mov_b32 s41, s17
    s_mov_b32 s42, 16384
    s_mov_b32 s43, 0x20000
    s_lshl_b32 s33, s46, 13
    s_add_u32 s33, s33, 458752
    s_add_u32 s32, s33, 4096
    v_bfe_u32 v1, v7, 2, 1
    v_lshlrev_b32 v2, 5, v1
    v_and_b32 v1, 16, v7
    v_add_u32 v2, v2, v1
    v_lshrrev_b32 v1, 5, v7
    v_lshl_add_u32 v2, v1, 3, v2
    v_and_b32 v1, 3, v7
    v_lshl_add_u32 v2, v1, 1, v2
    v_bfe_u32 v1, v7, 3, 1
    v_add_lshl_u32 v2, v2, v1, 1
    s_bfe_u32 s48, s46, 0x30001
    s_lshl_b32 s48, s48, 11
    s_lshr_b32 s54, s46, 4
    s_lshl_b32 s54, s54, 8
    s_add_u32 s48, s48, s54
    s_and_b32 s54, s46, 1
    s_lshl_b32 s54, s54, 7
    s_add_u32 s48, s48, s54
    s_mov_b32 s55, 0
L_poll2:
    buffer_load_dwordx4 v[32:35], v25, s[36:39], s33 offen offset:0 sc0 sc1
    buffer_load_dwordx4 v[36:39], v25, s[36:39], s33 offen offset:1024 sc0 sc1
    buffer_load_dwordx4 v[40:43], v25, s[36:39], s33 offen offset:2048 sc0 sc1
    buffer_load_dwordx4 v[44:47], v25, s[36:39], s33 offen offset:3072 sc0 sc1
    buffer_load_dwordx4 v[48:51], v25, s[36:39], s32 offen offset:0 sc0 sc1
    buffer_load_dwordx4 v[52:55], v25, s[36:39], s32 offen offset:1024 sc0 sc1
    buffer_load_dwordx4 v[56:59], v25, s[36:39], s32 offen offset:2048 sc0 sc1
    buffer_load_dwordx4 v[60:63], v25, s[36:39], s32 offen offset:3072 sc0 sc1
    s_add_u32 s55, s55, 1
    s_cmp_gt_u32 s55, 262144
    s_waitcnt vmcnt(6)
    v_bitop3_b32 v8, v33, v37, v236 bitop3:0x7e
    v_bitop3_b32 v9, v35, v39, v237 bitop3:0x7e
    v_add_f32 v16, v32, v36
    v_add_f32 v17, v34, v38
    s_waitcnt vmcnt(4)
    v_bitop3_b32 v10, v41, v45, v236 bitop3:0x7e
    v_bitop3_b32 v11, v43, v47, v237 bitop3:0x7e
    v_add_f32 v18, v40, v44
    v_add_f32 v19, v42, v46
    v_or3_b32 v8, v8, v9, v10
    v_pk_add_f32 v[16:17], v[16:17], v[18:19]
    s_waitcnt vmcnt(2)
    v_bitop3_b32 v12, v49, v53, v236 bitop3:0x7e
    v_bitop3_b32 v13, v51, v55, v237 bitop3:0x7e
    v_add_f32 v20, v48, v52
    v_add_f32 v21, v50, v54
    v_or3_b32 v11, v11, v12, v13
    s_waitcnt vmcnt(0)
    v_bitop3_b32 v14, v57, v61, v236 bitop3:0x7e
    v_bitop3_b32 v15, v59, v63, v237 bitop3:0x7e
    v_add_f32 v22, v56, v60
    v_add_f32 v23, v58, v62
    v_or3_b32 v8, v8, v14, v15
    v_pk_add_f32 v[20:21], v[20:21], v[22:23]
    v_or_b32 v8, v8, v11
    v_pk_add_f32 v[16:17], v[16:17], v[20:21]
    v_cmp_ne_u32 vcc, 0, v8
    s_cbranch_scc1 L_fin
    s_cbranch_vccnz L_poll2
L_fin:
    v_permlane32_swap_b32 v16, v17
    s_nop 1
    v_add_f32 v16, v16, v17
    v_cvt_pk_bf16_f32 v16, v16, v16
    buffer_store_short v16, v2, s[40:43], s48 offen
L_end:
    s_waitcnt vmcnt(0)
L_exit:
    s_endpgm
.section .rodata,"a"
.p2align 6
.amdhsa_kernel standalone__glu_gated_swiglu__decode_kernel
  .amdhsa_next_free_vgpr 240
  .amdhsa_next_free_sgpr 64
  .amdhsa_accum_offset 240
  .amdhsa_group_segment_fixed_size 0
  .amdhsa_kernarg_size 56
  .amdhsa_user_sgpr_count 2
  .amdhsa_user_sgpr_kernarg_segment_ptr 1
  .amdhsa_system_sgpr_workgroup_id_x 1
  .amdhsa_float_denorm_mode_32 3
.end_amdhsa_kernel
```
